```python
import torch

def _softmax(x, axis=-1):
    return torch.softmax(x, dim=axis)
def _gelu(x):
    return torch.nn.functional.gelu(x, approximate="tanh")
def _silu(x):
    return torch.nn.functional.silu(x)
def _sigmoid(x):
    return torch.sigmoid(x)
def _layernorm(x, axis=-1, eps=1e-5):
    m = x.mean(dim=axis, keepdim=True)
    v = x.var(dim=axis, keepdim=True, unbiased=False)
    return (x - m) / torch.sqrt(v + eps)
def _scatter_add(tgt, idx, src, axis=0):
    return tgt.clone().index_add_(axis, idx, src)
def _segment_sum(src, seg, n):
    out = torch.zeros((n,) + src.shape[1:], dtype=src.dtype)
    return out.index_add_(0, seg, src)
def _pad(x, pw):
    flat = tuple(v for pair in reversed(pw) for v in pair)
    return torch.nn.functional.pad(x, flat)

kernel_name = 'standalone__sliding_block_cached__decode'

def setup_inputs():

    _w = (lambda a: (lambda t: t.to(torch.bfloat16) if t.is_floating_point() else t)(torch.as_tensor(a)))
    B, Sq, D = 4, 1, 448
    Hq, Hkv, Sk, Dh = 16, 8, 4096, 256
    assert Hq % Hkv == 0, (Hq, Hkv)
    return {
        "x": _w((lambda *s: torch.randn(*s, dtype=torch.bfloat16) * 0.8)(B, Sq, D)),
        "k_cache": _w((lambda *s: torch.randn(*s, dtype=torch.bfloat16) * 0.8)(B, Hkv, Sk, Dh)),
        "v_cache": _w((lambda *s: torch.randn(*s, dtype=torch.bfloat16) * 0.05)(B, Hkv, Sk, Dh)),
        "wq": _w((lambda *s: torch.randn(*s, dtype=torch.bfloat16) * 0.8)(D, Hq * Dh) * (D ** -0.5)),
        "wo": _w((lambda *s: torch.randn(*s, dtype=torch.bfloat16) * 0.05)(Hq * Dh, D) * ((Hq * Dh) ** -0.5)),
    }

def reference(x, k_cache, v_cache, wq, wo):
    B, Sq, D = x.shape
    Hq, Dh = 16, 256
    Hkv, Sk = k_cache.shape[1], k_cache.shape[2]
    W = min(4096, max(256, Sk // 4))
    rep = Hq // Hkv
    q = (lambda x, *d: x.permute(*d))((x @ wq).reshape(B, Sq, Hq, Dh), 0, 2, 1, 3)
    k = (lambda x, n, axis: torch.repeat_interleave(x, n, dim=axis))(k_cache[:, :, Sk - W:, :], rep, axis=1)
    v = (lambda x, n, axis: torch.repeat_interleave(x, n, dim=axis))(v_cache[:, :, Sk - W:, :], rep, axis=1)
    scores = torch.einsum("bhqd,bhkd->bhqk", q, k) * (Dh ** -0.5)
    p = _softmax(scores, axis=-1)
    o = torch.einsum("bhqk,bhkd->bhqd", p, v)
    return (lambda x, *d: x.permute(*d))(o, 0, 2, 1, 3).reshape(B, Sq, Hq * Dh) @ wo
```

```asm
; @launch grid=(256,1,1) block=(320,1,1) lds=99456
.amdgcn_target "amdgcn-amd-amdhsa--gfx950"
.text
.p2align 13
.text
.globl standalone__sliding_block_cached__decode_kernel
.p2align 8
.type standalone__sliding_block_cached__decode_kernel,@function
standalone__sliding_block_cached__decode_kernel:
    s_load_dwordx16 s[4:19], s[0:1], 0
    s_cmpk_ge_u32 s2, 256
    s_cbranch_scc1 L_end
    v_readfirstlane_b32 s21, v0
    v_and_b32 v0, 63, v0
    s_brev_b32 s20, s2
    s_lshr_b32 s20, s20, 29
    s_lshr_b32 s22, s2, 3
    v_lshrrev_b32 v6, 4, v0
    s_bitcmp0_b32 s21, 8
    s_cbranch_scc1 L_work
    v_lshrrev_b32 v7, 3, v0
    v_and_b32 v8, 6, v7
    v_xor_b32 v8, v8, v0
    v_and_b32 v8, 7, v8
    v_lshlrev_b32 v7, 13, v7
    v_lshl_add_u32 v7, v8, 4, v7
    s_lshr_b32 s25, s2, 6
    s_mul_i32 s28, s25, 916480
    s_lshl3_add_u32 s29, s20, s22
    s_lshl_b32 s29, s29, 7
    s_add_u32 s28, s28, s29
    v_add_u32 v7, s28, v7
    v_and_b32 v8, 15, v0
    v_min_u32 v8, 13, v8
    v_mad_u32_u24 v8, v6, 56, v8
    s_mul_i32 s28, s25, 14
    v_add_lshl_u32 v8, v8, s28, 4
    v_and_b32 v4, 3, v0
    v_bfe_u32 v5, v0, 2, 2
    s_lshl_b32 s27, s20, 15
    s_add_u32 s27, s27, 262144
    s_lshl_b32 s29, s22, 8
    s_add_u32 s29, s27, s29
    v_lshlrev_b32 v13, 13, v5
    v_lshl_add_u32 v13, v6, 6, v13
    v_lshl_add_u32 v13, v4, 4, v13
    v_add_u32 v13, s29, v13
    s_mov_b32 m0, 81920
    s_lshl_b32 s28, 1, 16
    s_movk_i32 s29, 6
    s_cmp_lg_u32 s2, 1
    s_waitcnt lgkmcnt(0)
    s_cbranch_scc0 L_race
L_wq:
    global_load_lds_dwordx4 v7, s[10:11] nt
    s_addk_i32 m0, 1024
    v_add_u32 v7, s28, v7
    global_load_lds_dwordx4 v7, s[10:11] nt
    s_addk_i32 m0, 1024
    v_add_u32 v7, s28, v7
    s_sub_u32 s29, s29, 1
    s_cbranch_scc0 L_wq
    global_load_lds_dwordx4 v8, s[4:5]
    global_load_dword v3, v13, s[18:19] sc1
    s_cmp_lg_u32 s2, 1
    s_cbranch_scc0 L_raced
L_go:
    s_barrier
    s_branch L_comm
L_race:
    s_load_dword s36, s[18:19], 0x8000 glc
    s_load_dwordx2 s[38:39], s[18:19], 0xa000 glc
    s_branch L_wq
L_raced:
    s_mov_b64 exec, 1
    s_waitcnt lgkmcnt(2)
    s_getreg_b32 s37, hwreg(HW_REG_IB_STS, 9, 1)
    v_subrev_u32 v10, s37, v0
    v_add_u32 v10, 3, v10
    global_store_dword v0, v10, s[16:17] sc1
    s_mov_b64 exec, -1
    s_branch L_go
L_work:
    s_getpc_b64 s[26:27]
    s_lshl_b32 s3, s22, 8
    v_lshl_add_u32 v2, v0, 2, s3
    global_load_dword v3, v2, s[26:27]
    v_and_b32 v4, 3, v0
    v_bfe_u32 v5, v0, 2, 2
    v_lshlrev_b32 v1, 4, v4
    v_lshl_add_u32 v1, v5, 11, v1
    v_lshl_add_u32 v1, v6, 6, v1
    s_and_b32 s25, s2, 24
    s_or_b32 s25, s25, s20
    s_lshr_b32 s24, s2, 5
    s_lshl_b32 s28, s25, 21
    s_mul_i32 s29, s24, 0x11000
    s_or_b32 s28, s28, s29
    s_and_b32 s29, s25, 8
    s_lshl_b32 s29, s29, 12
    s_or_b32 s28, s28, s29
    s_lshl_b32 s29, s21, 8
    s_xor_b32 s29, s28, s29
    s_or_b32 s29, s29, 1572864
    v_xor_b32 v1, s29, v1
    v_xor_b32 v2, 0x2000, v1
    s_waitcnt lgkmcnt(0)
    s_barrier
    global_load_dwordx4 v[64:67], v1, s[6:7] offset:0 nt
    global_load_dwordx4 v[68:71], v1, s[6:7] offset:256 nt
    global_load_dwordx4 v[72:75], v1, s[6:7] offset:512 nt
    global_load_dwordx4 v[76:79], v1, s[6:7] offset:768 nt
    global_load_dwordx4 v[80:83], v1, s[6:7] offset:1024 nt
    global_load_dwordx4 v[84:87], v1, s[6:7] offset:1280 nt
    global_load_dwordx4 v[88:91], v1, s[6:7] offset:1536 nt
    global_load_dwordx4 v[92:95], v1, s[6:7] offset:1792 nt
    global_load_dwordx4 v[96:99], v2, s[6:7] offset:0 nt
    global_load_dwordx4 v[100:103], v2, s[6:7] offset:256 nt
    global_load_dwordx4 v[104:107], v2, s[6:7] offset:512 nt
    global_load_dwordx4 v[108:111], v2, s[6:7] offset:768 nt
    global_load_dwordx4 v[112:115], v2, s[6:7] offset:1024 nt
    s_lshr_b32 s26, s21, 6
    s_lshr_b32 s23, s25, 3
    s_and_b32 s27, s28, 0xf000
    v_lshrrev_b32 v7, 3, v0
    v_and_b32 v8, 6, v7
    v_xor_b32 v8, v8, v0
    v_and_b32 v8, 7, v8
    v_lshlrev_b32 v8, 4, v8
    v_mul_u32_u24 v9, 896, v7
    v_add_u32 v9, v9, v8
    v_lshl_add_u32 v8, v7, 9, v8
    s_xor_b32 s28, s28, s27
    s_lshl1_add_u32 s28, s21, s28
    s_add_u32 s28, s28, 1572864
    s_add_u32 s40, s8, s28
    s_addc_u32 s41, s9, 0
    s_mov_b32 s42, 65152
    s_mov_b32 s43, 0x20000
    s_lshr_b32 s3, s22, 2
    s_and_b32 s31, s22, 3
    s_lshl3_add_u32 s33, s20, s3
    s_and_b32 s29, s26, 1
    s_lshl1_add_u32 s28, s33, s29
    s_mul_i32 s28, s28, 28672
    s_lshr_b32 s29, s26, 1
    s_lshl1_add_u32 s44, s31, s29
    s_lshl_b32 s29, s44, 7
    s_add_u32 s28, s28, s29
    s_add_u32 s36, s12, s28
    s_addc_u32 s37, s13, 0
    s_sub_u32 s38, 28672, s29
    s_cmp_eq_u32 s44, 7
    s_cselect_b32 s38, 0, s38
    s_mov_b32 s39, 0x20000
    s_lshl_b32 s34, s26, 14
    s_lshl_b32 s45, s26, 12
    s_add_u32 s45, s45, 65536
    s_movk_i32 s46, 7168
    s_movk_i32 s47, 14336
    s_movk_i32 s52, 21504
    v_and_b32 v7, 1, v0
    v_lshlrev_b32 v10, 9, v7
    v_lshl_add_u32 v10, v6, 6, v10
    v_lshl_add_u32 v10, v5, 4, v10
    v_add_u32 v10, 97280, v10
    v_mov_b32 v11, 98304
    v_lshrrev_b32 v12, 2, v0
    v_lshlrev_b32 v12, 7, v12
    v_lshl_add_u32 v12, v4, 3, v12
    v_bfe_u32 v13, v0, 3, 2
    v_lshl_add_u32 v12, v13, 5, v12
    s_mul_i32 s29, s21, 65
    s_and_b32 s29, s29, 0x2040
    s_or_b32 s29, s29, 65536
    v_xor_b32 v216, s29, v12
    v_xor_b32 v217, 32, v216
    v_add_u32 v12, s34, v12
    v_xor_b32 v13, 32, v12
    v_xor_b32 v14, 64, v12
    v_xor_b32 v15, 96, v12
    v_lshlrev_b32 v192, 8, v7
    v_lshl_add_u32 v192, v6, 4, v192
    s_mov_b32 s55, 98368
    s_add_u32 s29, s21, s55
    v_lshl_add_u32 v193, v5, 3, v192
    v_add_u32 v193, s29, v193
    v_and_b32 v195, 1, v5
    v_lshlrev_b32 v195, 8, v195
    v_lshl_add_u32 v194, v4, 6, v195
    v_and_b32 v196, 56, v0
    v_add3_u32 v194, v194, v196, s55
    s_lshl3_add_u32 s28, s26, s20
    s_lshr_b32 s29, s3, 2
    s_lshl1_add_u32 s28, s28, s29
    s_lshl_b32 s28, s28, 8
    s_add_u32 s28, s28, 16384
    v_and_b32 v201, 15, v0
    v_lshl_add_u32 v201, v201, 4, s28
    s_and_b32 s29, s24, 3
    s_lshl3_add_u32 s29, s25, s29
    s_lshl_b32 s29, s29, 6
    s_lshr_b32 s30, s24, 2
    s_lshl3_add_u32 s29, s30, s29
    s_add_u32 s29, s29, 16384
    v_lshl_add_u32 v200, v4, 4, v195
    v_add_u32 v200, s29, v200
    v_lshrrev_b32 v207, 1, v0
    v_lshlrev_b32 v202, 6, v6
    v_lshl_add_u32 v202, v4, 4, v202
    s_lshl2_add_u32 s29, s33, s26
    s_lshl_b32 s29, s29, 11
    s_add_u32 s29, s29, 524288
    v_lshl_add_u32 v203, v5, 8, v202
    v_add_u32 v203, s29, v203
    s_lshl3_add_u32 s28, s20, s26
    s_lshl2_add_u32 s28, s28, s23
    s_lshl3_add_u32 s28, s28, s24
    s_lshl_b32 s28, s28, 8
    s_add_u32 s28, s28, 524288
    v_lshl_add_u32 v202, v5, 15, v202
    v_add_u32 v202, s28, v202
    v_and_b32 v62, 2, v0
    v_lshlrev_b32 v62, 5, v62
    v_lshl_add_u32 v62, v7, 3, v62
    v_lshl_add_u32 v62, v6, 4, v62
    s_mul_i32 s29, s26, 144
    s_add_u32 s29, s29, 98880
    v_add_u32 v214, s29, v62
    v_mad_u32_u24 v215, v4, 9, v6
    v_lshlrev_b32 v215, 4, v215
    v_add_u32 v215, 98880, v215
    s_lshr_b32 s28, s33, 1
    s_mul_i32 s28, s28, 0x4080
    s_and_b32 s29, s33, 1
    s_lshl2_add_u32 s29, s29, s31
    s_lshl_b32 s29, s29, 10
    s_xor_b32 s28, s28, s29
    s_mul_i32 s29, s21, 72
    s_and_b32 s29, s29, 0x2200
    s_xor_b32 s28, s28, s29
    s_xor_b32 s30, s28, 1048576
    v_lshlrev_b32 v204, 4, v0
    v_xor_b32 v204, s30, v204
    v_lshlrev_b32 v211, 7, v4
    v_xor_b32 v211, s30, v211
    s_mul_i32 s29, s20, 0x2200
    s_and_b32 s29, s29, 0x2c00
    s_lshl_b32 s28, s22, 5
    s_or_b32 s29, s29, s28
    s_xor_b32 s29, s29, 1048576
    v_mul_u32_u24 v205, 0x4080, v207
    v_lshl_add_u32 v205, v7, 4, v205
    v_xor_b32 v205, s29, v205
    v_xor_b32 v207, 0x1000, v205
    s_lshl_b32 s28, s20, 5
    s_add_u32 s28, s28, s22
    s_lshl_b32 s28, s28, 2
    v_mul_u32_u24 v206, 896, v6
    v_add_u32 v206, s28, v206
    v_cmp_gt_u32 vcc, 2, v5
    s_nop 1
    v_cndmask_b32 v210, v200, v202, vcc
    s_mov_b32 s35, 0x3db8aa3b
    s_mov_b32 s32, 1048576
    s_mov_b64 s[50:51], -1
    s_movk_i32 s48, 0xff
    s_mov_b32 s49, 0xffff
    s_mov_b32 s53, 0x193311
    s_waitcnt vmcnt(8)
    global_load_dwordx4 v[116:119], v2, s[6:7] offset:1280 nt
    s_waitcnt vmcnt(8)
    global_load_dwordx4 v[120:123], v2, s[6:7] offset:1536 nt
    s_waitcnt vmcnt(7)
    global_load_dwordx4 v[124:127], v2, s[6:7] offset:1792 nt
    s_add_u32 m0, s34, 0
    s_xor_b32 s29, s27, 0
    s_waitcnt vmcnt(7)
    buffer_load_dwordx4 v8, s[40:43], s29 offen nt lds
    s_add_u32 m0, s34, 1024
    s_xor_b32 s29, s27, 4096
    s_waitcnt vmcnt(7)
    buffer_load_dwordx4 v8, s[40:43], s29 offen nt lds
    s_add_u32 m0, s34, 2048
    s_xor_b32 s29, s27, 8192
    s_waitcnt vmcnt(6)
    buffer_load_dwordx4 v8, s[40:43], s29 offen nt lds
    s_add_u32 m0, s34, 3072
    s_xor_b32 s29, s27, 12288
    s_waitcnt vmcnt(6)
    buffer_load_dwordx4 v8, s[40:43], s29 offen nt lds
    s_add_u32 m0, s34, 4096
    s_xor_b32 s29, s27, 16384
    s_waitcnt vmcnt(6)
    buffer_load_dwordx4 v8, s[40:43], s29 offen nt lds
    s_add_u32 m0, s34, 5120
    s_xor_b32 s29, s27, 20480
    s_waitcnt vmcnt(6)
    buffer_load_dwordx4 v8, s[40:43], s29 offen nt lds
    s_add_u32 m0, s34, 6144
    s_xor_b32 s29, s27, 24576
    s_waitcnt vmcnt(5)
    buffer_load_dwordx4 v8, s[40:43], s29 offen nt lds
    s_add_u32 m0, s34, 7168
    s_xor_b32 s29, s27, 28672
    s_waitcnt vmcnt(5)
    buffer_load_dwordx4 v8, s[40:43], s29 offen nt lds
    s_add_u32 m0, s34, 8192
    s_xor_b32 s29, s27, 32768
    s_waitcnt vmcnt(5)
    buffer_load_dwordx4 v8, s[40:43], s29 offen nt lds
    s_add_u32 m0, s34, 9216
    s_xor_b32 s29, s27, 36864
    s_waitcnt vmcnt(4)
    buffer_load_dwordx4 v8, s[40:43], s29 offen nt lds
    s_add_u32 m0, s34, 10240
    s_xor_b32 s29, s27, 40960
    s_waitcnt vmcnt(4)
    buffer_load_dwordx4 v8, s[40:43], s29 offen nt lds
    s_add_u32 m0, s34, 11264
    s_xor_b32 s29, s27, 45056
    s_waitcnt vmcnt(4)
    buffer_load_dwordx4 v8, s[40:43], s29 offen nt lds
    s_add_u32 m0, s34, 12288
    s_xor_b32 s29, s27, 49152
    s_waitcnt vmcnt(4)
    buffer_load_dwordx4 v8, s[40:43], s29 offen nt lds
    s_waitcnt vmcnt(9)
    ds_read_b64_tr_b16 v[128:129], v12 offset:0
    ds_read_b64_tr_b16 v[130:131], v12 offset:2048
    ds_read_b64_tr_b16 v[132:133], v13 offset:0
    ds_read_b64_tr_b16 v[134:135], v13 offset:2048
    ds_read_b64_tr_b16 v[136:137], v14 offset:0
    ds_read_b64_tr_b16 v[138:139], v14 offset:2048
    ds_read_b64_tr_b16 v[140:141], v15 offset:0
    ds_read_b64_tr_b16 v[142:143], v15 offset:2048
    s_waitcnt vmcnt(5)
    ds_read_b64_tr_b16 v[144:145], v12 offset:4096
    ds_read_b64_tr_b16 v[146:147], v12 offset:6144
    ds_read_b64_tr_b16 v[148:149], v13 offset:4096
    ds_read_b64_tr_b16 v[150:151], v13 offset:6144
    ds_read_b64_tr_b16 v[152:153], v14 offset:4096
    ds_read_b64_tr_b16 v[154:155], v14 offset:6144
    ds_read_b64_tr_b16 v[156:157], v15 offset:4096
    ds_read_b64_tr_b16 v[158:159], v15 offset:6144
    s_waitcnt lgkmcnt(0)
    s_barrier
    ds_read_b128 v[16:19], v10
    ds_read_b128 v[20:23], v10 offset:256
    ds_read_b64 v[208:209], v11
    s_add_u32 m0, s34, 13312
    s_xor_b32 s29, s27, 53248
    buffer_load_dwordx4 v8, s[40:43], s29 offen nt lds
    s_add_u32 m0, s34, 14336
    s_xor_b32 s29, s27, 57344
    buffer_load_dwordx4 v8, s[40:43], s29 offen nt lds
    s_add_u32 m0, s34, 15360
    s_xor_b32 s29, s27, 61440
    buffer_load_dwordx4 v8, s[40:43], s29 offen nt lds
    s_waitcnt lgkmcnt(0)
    v_mfma_f32_16x16x32_bf16 v[32:35], v[64:67], v[16:19], 0
    v_mad_u32_u24 v218, v4, s53, v208
    v_mfma_f32_16x16x32_bf16 v[32:35], v[68:71], v[20:23], v[32:35]
    v_mad_u32_u24 v223, v7, s53, v208
    v_mfma_f32_16x16x32_bf16 v[36:39], v[72:75], v[16:19], 0
    v_bfe_u32 v219, v218, 16, 8
    v_mfma_f32_16x16x32_bf16 v[36:39], v[76:79], v[20:23], v[36:39]
    v_readfirstlane_b32 s54, v209
    v_mfma_f32_16x16x32_bf16 v[40:43], v[80:83], v[16:19], 0
    v_and_b32 v209, 0x2000, v209
    v_xor_b32 v204, v209, v204
    v_mfma_f32_16x16x32_bf16 v[40:43], v[84:87], v[20:23], v[40:43]
    v_xor_b32 v205, v209, v205
    v_xor_b32 v207, v209, v207
    v_mfma_f32_16x16x32_bf16 v[44:47], v[88:91], v[16:19], 0
    v_bfe_u32 v220, v223, 0, 8
    v_mfma_f32_16x16x32_bf16 v[44:47], v[92:95], v[20:23], v[44:47]
    v_bfe_u32 v221, v223, 8, 8
    v_mfma_f32_16x16x32_bf16 v[48:51], v[96:99], v[16:19], 0
    v_bfe_u32 v222, v223, 16, 8
    v_mfma_f32_16x16x32_bf16 v[48:51], v[100:103], v[20:23], v[48:51]
    v_bfe_u32 v223, v223, 24, 8
    v_mfma_f32_16x16x32_bf16 v[52:55], v[104:107], v[16:19], 0
    v_mfma_f32_16x16x32_bf16 v[52:55], v[108:111], v[20:23], v[52:55]
    v_add_f32_dpp v24, v33, v32 row_ror:12 row_mask:0xf bank_mask:0x1
    v_add_f32_dpp v25, v37, v36 row_ror:12 row_mask:0xf bank_mask:0x1
    v_mfma_f32_16x16x32_bf16 v[56:59], v[112:115], v[16:19], 0
    v_add_f32_dpp v26, v41, v40 row_ror:12 row_mask:0xf bank_mask:0x1
    v_add_f32_dpp v27, v45, v44 row_ror:12 row_mask:0xf bank_mask:0x1
    v_mfma_f32_16x16x32_bf16 v[56:59], v[116:119], v[20:23], v[56:59]
    v_add_f32_dpp v24, v34, v24 row_ror:8 row_mask:0xf bank_mask:0x1
    v_add_f32_dpp v25, v38, v25 row_ror:8 row_mask:0xf bank_mask:0x1
    v_mfma_f32_16x16x32_bf16 v[60:63], v[120:123], v[16:19], 0
    v_add_f32_dpp v26, v42, v26 row_ror:8 row_mask:0xf bank_mask:0x1
    v_add_f32_dpp v27, v46, v27 row_ror:8 row_mask:0xf bank_mask:0x1
    v_mfma_f32_16x16x32_bf16 v[60:63], v[124:127], v[20:23], v[60:63]
    v_add_f32_dpp v24, v35, v24 row_ror:4 row_mask:0xf bank_mask:0x1
    v_add_f32_dpp v25, v39, v25 row_ror:4 row_mask:0xf bank_mask:0x1
    v_add_f32_dpp v26, v43, v26 row_ror:4 row_mask:0xf bank_mask:0x1
    v_add_f32_dpp v27, v47, v27 row_ror:4 row_mask:0xf bank_mask:0x1
    s_nop 0
    v_add_f32_dpp v24, v50, v49 row_ror:12 row_mask:0xf bank_mask:0x2
    v_add_f32_dpp v25, v54, v53 row_ror:12 row_mask:0xf bank_mask:0x2
    v_add_f32_dpp v26, v58, v57 row_ror:12 row_mask:0xf bank_mask:0x2
    v_add_f32_dpp v27, v62, v61 row_ror:12 row_mask:0xf bank_mask:0x2
    v_add_f32_dpp v24, v51, v24 row_ror:8 row_mask:0xf bank_mask:0x2
    v_add_f32_dpp v25, v55, v25 row_ror:8 row_mask:0xf bank_mask:0x2
    v_add_f32_dpp v26, v59, v26 row_ror:8 row_mask:0xf bank_mask:0x2
    v_add_f32_dpp v27, v63, v27 row_ror:8 row_mask:0xf bank_mask:0x2
    v_add_f32_dpp v24, v48, v24 row_ror:4 row_mask:0xf bank_mask:0x2
    v_add_f32_dpp v25, v52, v25 row_ror:4 row_mask:0xf bank_mask:0x2
    v_add_f32_dpp v26, v56, v26 row_ror:4 row_mask:0xf bank_mask:0x2
    v_add_f32_dpp v27, v60, v27 row_ror:4 row_mask:0xf bank_mask:0x2
    s_mov_b32 exec_lo, 0x00330033
    s_mov_b32 exec_hi, 0x00330033
    v_cvt_pk_bf16_f32 v28, v24, v25
    v_cvt_pk_bf16_f32 v29, v26, v27
    ds_write_b64 v193, v[28:29]
    s_mov_b64 exec, -1
    s_waitcnt lgkmcnt(0)
    s_barrier
    ds_read_b64 v[28:29], v194
    s_waitcnt lgkmcnt(0)
    v_lshlrev_b32 v32, 16, v28
    v_and_b32 v33, 0xffff0000, v28
    v_lshlrev_b32 v34, 16, v29
    v_and_b32 v35, 0xffff0000, v29
    v_max3_f32 v24, v32, v33, v34
    v_max_f32 v24, v24, v35
    s_nop 1
    v_max_f32_dpp v24, v24, v24 row_ror:8 row_mask:0xf bank_mask:0xf
    s_nop 1
    v_max_f32_dpp v24, v24, v24 quad_perm:[2,3,0,1] row_mask:0xf bank_mask:0xf
    s_nop 1
    v_max_f32_dpp v24, v24, v24 quad_perm:[1,0,3,2] row_mask:0xf bank_mask:0xf
    v_mov_b32 v25, v24
    s_nop 1
    v_permlane16_swap_b32 v24, v25
    v_max_f32 v24, v24, v25
    v_mov_b32 v25, v24
    s_nop 1
    v_permlane32_swap_b32 v24, v25
    v_max_f32 v24, v24, v25
    v_pk_add_f32 v[32:33], v[32:33], v[24:25] op_sel_hi:[1,0] neg_lo:[0,1] neg_hi:[0,1]
    v_pk_add_f32 v[34:35], v[34:35], v[24:25] op_sel_hi:[1,0] neg_lo:[0,1] neg_hi:[0,1]
    v_pk_mul_f32 v[32:33], v[32:33], s[34:35] op_sel:[0,1]
    v_pk_mul_f32 v[34:35], v[34:35], s[34:35] op_sel:[0,1]
    v_exp_f32 v32, v32
    v_exp_f32 v33, v33
    v_exp_f32 v34, v34
    v_exp_f32 v35, v35
    v_cvt_pk_bf16_f32 v28, v32, v33
    v_add_f32 v25, v32, v33
    v_cvt_pk_bf16_f32 v29, v34, v35
    v_add_f32 v26, v34, v35
    v_mov_b32_dpp v30, v28 row_ror:8 row_mask:0xf bank_mask:0xf
    v_add_f32 v25, v25, v26
    v_mov_b32_dpp v31, v29 row_ror:8 row_mask:0xf bank_mask:0xf
    v_mov_b32_dpp v64, v28 quad_perm:[0,0,0,0] row_mask:0xf bank_mask:0xf
    v_mov_b32_dpp v65, v29 quad_perm:[0,0,0,0] row_mask:0xf bank_mask:0xf
    v_add_f32_dpp v25, v25, v25 row_ror:8 row_mask:0xf bank_mask:0xf
    v_mov_b32_dpp v66, v30 quad_perm:[0,0,0,0] row_mask:0xf bank_mask:0xf
    v_mov_b32_dpp v67, v31 quad_perm:[0,0,0,0] row_mask:0xf bank_mask:0xf
    v_add_f32_dpp v25, v25, v25 quad_perm:[2,3,0,1] row_mask:0xf bank_mask:0xf
    v_mov_b32_dpp v68, v28 quad_perm:[1,1,1,1] row_mask:0xf bank_mask:0xf
    v_mov_b32_dpp v69, v29 quad_perm:[1,1,1,1] row_mask:0xf bank_mask:0xf
    v_add_f32_dpp v25, v25, v25 quad_perm:[1,0,3,2] row_mask:0xf bank_mask:0xf
    v_mov_b32 v26, v25
    v_mov_b32_dpp v70, v30 quad_perm:[1,1,1,1] row_mask:0xf bank_mask:0xf
    v_mov_b32_dpp v71, v31 quad_perm:[1,1,1,1] row_mask:0xf bank_mask:0xf
    v_permlane16_swap_b32 v25, v26
    v_add_f32 v25, v25, v26
    v_mov_b32 v26, v25
    v_mov_b32_dpp v72, v28 quad_perm:[2,2,2,2] row_mask:0xf bank_mask:0xf
    v_mov_b32_dpp v73, v29 quad_perm:[2,2,2,2] row_mask:0xf bank_mask:0xf
    v_permlane32_swap_b32 v25, v26
    v_add_f32 v25, v25, v26
    v_bfi_b32 v212, s49, v218, v24
    v_bfi_b32 v213, s48, v219, v25
    s_cmp_lg_u32 s26, 0
    s_cbranch_scc1 L_nostat
    s_mov_b64 exec, 0xff
    s_bitcmp1_b32 s54, 0
    s_cbranch_scc1 L_statfar
    global_store_dwordx2 v200, v[212:213], s[18:19]
L_statdone:
    s_mov_b64 exec, -1
L_nostat:
    v_mov_b32_dpp v74, v30 quad_perm:[2,2,2,2] row_mask:0xf bank_mask:0xf
    v_mov_b32_dpp v75, v31 quad_perm:[2,2,2,2] row_mask:0xf bank_mask:0xf
    v_mov_b32_dpp v76, v28 quad_perm:[3,3,3,3] row_mask:0xf bank_mask:0xf
    v_mov_b32_dpp v77, v29 quad_perm:[3,3,3,3] row_mask:0xf bank_mask:0xf
    v_mov_b32_dpp v78, v30 quad_perm:[3,3,3,3] row_mask:0xf bank_mask:0xf
    v_mov_b32_dpp v79, v31 quad_perm:[3,3,3,3] row_mask:0xf bank_mask:0xf
    global_load_dword v210, v210, s[18:19] sc1
    s_waitcnt lgkmcnt(0)
    v_mfma_f32_16x16x32_bf16 v[32:35], v[128:131], v[64:67], 0
    v_mfma_f32_16x16x32_bf16 v[36:39], v[132:135], v[64:67], 0
    v_mfma_f32_16x16x32_bf16 v[40:43], v[136:139], v[64:67], 0
    v_mfma_f32_16x16x32_bf16 v[44:47], v[140:143], v[64:67], 0
    v_mfma_f32_16x16x32_bf16 v[32:35], v[144:147], v[68:71], v[32:35]
    v_mfma_f32_16x16x32_bf16 v[36:39], v[148:151], v[68:71], v[36:39]
    v_mfma_f32_16x16x32_bf16 v[40:43], v[152:155], v[68:71], v[40:43]
    v_mfma_f32_16x16x32_bf16 v[44:47], v[156:159], v[68:71], v[44:47]
    s_add_u32 m0, s45, 0
    s_nop 0
    buffer_load_dwordx4 v9, s[36:39], 0 offen nt lds
    s_add_u32 m0, s45, 1024
    s_nop 0
    buffer_load_dwordx4 v9, s[36:39], s46 offen nt lds
    s_waitcnt vmcnt(7)
    ds_read_b64_tr_b16 v[160:161], v12 offset:8192
    ds_read_b64_tr_b16 v[162:163], v12 offset:10240
    ds_read_b64_tr_b16 v[164:165], v13 offset:8192
    ds_read_b64_tr_b16 v[166:167], v13 offset:10240
    ds_read_b64_tr_b16 v[168:169], v14 offset:8192
    ds_read_b64_tr_b16 v[170:171], v14 offset:10240
    ds_read_b64_tr_b16 v[172:173], v15 offset:8192
    ds_read_b64_tr_b16 v[174:175], v15 offset:10240
    s_waitcnt lgkmcnt(6)
    v_mfma_f32_16x16x32_bf16 v[32:35], v[160:163], v[72:75], v[32:35]
    s_waitcnt lgkmcnt(4)
    v_mfma_f32_16x16x32_bf16 v[36:39], v[164:167], v[72:75], v[36:39]
    s_waitcnt lgkmcnt(2)
    v_mfma_f32_16x16x32_bf16 v[40:43], v[168:171], v[72:75], v[40:43]
    s_waitcnt lgkmcnt(0)
    v_mfma_f32_16x16x32_bf16 v[44:47], v[172:175], v[72:75], v[44:47]
    global_load_dwordx4 v[48:51], v201, s[18:19] sc1
    s_add_u32 m0, s45, 2048
    s_nop 0
    buffer_load_dwordx4 v9, s[36:39], s47 offen nt lds
    s_add_u32 m0, s45, 3072
    s_nop 0
    buffer_load_dwordx4 v9, s[36:39], s52 offen nt lds
    global_load_dword v211, v211, s[18:19] sc1
    s_waitcnt vmcnt(9)
    ds_read_b64_tr_b16 v[176:177], v12 offset:12288
    ds_read_b64_tr_b16 v[180:181], v13 offset:12288
    ds_read_b64_tr_b16 v[184:185], v14 offset:12288
    ds_read_b64_tr_b16 v[188:189], v15 offset:12288
    s_waitcnt vmcnt(7)
    ds_read_b64_tr_b16 v[178:179], v12 offset:14336
    ds_read_b64_tr_b16 v[182:183], v13 offset:14336
    ds_read_b64_tr_b16 v[186:187], v14 offset:14336
    ds_read_b64_tr_b16 v[190:191], v15 offset:14336
    s_waitcnt lgkmcnt(3)
    v_mfma_f32_16x16x32_bf16 v[32:35], v[176:179], v[76:79], v[32:35]
    s_waitcnt lgkmcnt(2)
    v_mfma_f32_16x16x32_bf16 v[36:39], v[180:183], v[76:79], v[36:39]
    s_waitcnt lgkmcnt(1)
    v_mfma_f32_16x16x32_bf16 v[40:43], v[184:187], v[76:79], v[40:43]
    s_waitcnt lgkmcnt(0)
    v_mfma_f32_16x16x32_bf16 v[44:47], v[188:191], v[76:79], v[44:47]
    s_mov_b32 exec_lo, 0x00110011
    s_mov_b32 exec_hi, 0x00110011
    v_bfi_b32 v56, s48, v220, v32
    v_bfi_b32 v57, s48, v221, v33
    v_bfi_b32 v58, s48, v222, v34
    v_bfi_b32 v59, s48, v223, v35
    s_lshl_b64 exec, exec, 1
    v_bfi_b32 v56, s48, v220, v36
    v_bfi_b32 v57, s48, v221, v37
    v_bfi_b32 v58, s48, v222, v38
    v_bfi_b32 v59, s48, v223, v39
    s_lshl_b64 exec, exec, 1
    v_bfi_b32 v56, s48, v220, v40
    v_bfi_b32 v57, s48, v221, v41
    v_bfi_b32 v58, s48, v222, v42
    v_bfi_b32 v59, s48, v223, v43
    s_lshl_b64 exec, exec, 1
    v_bfi_b32 v56, s48, v220, v44
    v_bfi_b32 v57, s48, v221, v45
    v_bfi_b32 v58, s48, v222, v46
    v_bfi_b32 v59, s48, v223, v47
    s_wqm_b64 exec, exec
    s_bitcmp1_b32 s54, 0
    s_cbranch_scc1 L_xfar
    global_store_dwordx4 v202, v[56:59], s[18:19]
L_xdone:
    s_mov_b64 exec, -1
    s_waitcnt vmcnt(4)
L_schk:
    v_cmpx_eq_u32_sdwa vcc, v49, v219 src0_sel:BYTE_0 src1_sel:DWORD
    v_cmpx_eq_u32_sdwa vcc, v51, v219 src0_sel:BYTE_0 src1_sel:DWORD
    v_cmpx_eq_u16 vcc, v48, v218
    v_cmpx_eq_u16 vcc, v50, v218
    s_cmp_eq_u64 exec, -1
    s_mov_b64 exec, -1
    s_cbranch_scc0 L_sretry
L_sgot:
    v_and_b32 v48, 0xffff0000, v48
    v_and_b32 v50, 0xffff0000, v50
    v_max_f32 v24, v48, v50
    v_xor_b32 v49, v219, v49
    v_xor_b32 v51, v219, v51
    v_max_f32_dpp v24, v24, v24 row_ror:4 row_mask:0xf bank_mask:0xf
    s_nop 1
    v_max_f32_dpp v24, v24, v24 row_ror:8 row_mask:0xf bank_mask:0xf
    v_sub_f32 v48, v48, v24
    v_sub_f32 v50, v50, v24
    v_mul_f32 v48, s35, v48
    v_mul_f32 v50, s35, v50
    v_exp_f32 v48, v48
    v_exp_f32 v50, v50
    v_mul_f32 v25, v48, v49
    v_fmac_f32 v25, v50, v51
    s_nop 1
    v_add_f32_dpp v25, v25, v25 row_ror:8 row_mask:0xf bank_mask:0xf
    s_nop 1
    v_add_f32_dpp v25, v25, v25 row_ror:4 row_mask:0xf bank_mask:0xf
    v_rcp_f32 v25, v25
    s_mov_b32 s32, 1048576
    v_mul_f32 v48, v48, v25
    v_mul_f32 v50, v50, v25
    global_load_dwordx4 v[40:43], v203, s[18:19] sc1
    global_load_dwordx4 v[44:47], v203, s[18:19] offset:1024 sc1
    s_branch L_xchk
L_xretry:
    s_sub_u32 s32, s32, 1
    s_cbranch_scc1 L_xgot
    s_mov_b64 exec, s[50:51]
    global_load_dwordx4 v[40:43], v203, s[18:19] sc1
    global_load_dwordx4 v[44:47], v203, s[18:19] offset:1024 sc1
L_xchk:
    s_waitcnt vmcnt(0)
    v_xor_b32 v40, v220, v40
    v_xor_b32 v41, v221, v41
    v_xor_b32 v42, v222, v42
    v_xor_b32 v43, v223, v43
    v_xor_b32 v44, v220, v44
    v_xor_b32 v45, v221, v45
    v_xor_b32 v46, v222, v46
    v_xor_b32 v47, v223, v47
    v_or3_b32 v24, v40, v41, v42
    v_or3_b32 v25, v43, v44, v45
    v_or3_b32 v26, v46, v47, v24
    v_or_b32 v27, v25, v26
    v_cmpx_eq_u32_sdwa vcc, v27, 0 src0_sel:BYTE_0 src1_sel:DWORD
    s_andn2_b64 s[50:51], s[50:51], exec
    s_wqm_b64 s[50:51], s[50:51]
    s_cbranch_scc1 L_xretry
L_xgot:
    s_mov_b64 exec, -1
    v_pk_mul_f32 v[40:41], v[40:41], v[48:49] op_sel_hi:[1,0]
    v_pk_mul_f32 v[42:43], v[42:43], v[48:49] op_sel_hi:[1,0]
    v_pk_fma_f32 v[40:41], v[44:45], v[50:51], v[40:41] op_sel_hi:[1,0,1]
    v_pk_fma_f32 v[42:43], v[46:47], v[50:51], v[42:43] op_sel_hi:[1,0,1]
    s_nop 0
    v_add_f32_dpp v40, v40, v40 row_ror:8 row_mask:0xf bank_mask:0xf
    v_add_f32_dpp v41, v41, v41 row_ror:8 row_mask:0xf bank_mask:0xf
    v_add_f32_dpp v42, v42, v42 row_ror:8 row_mask:0xf bank_mask:0xf
    v_add_f32_dpp v43, v43, v43 row_ror:8 row_mask:0xf bank_mask:0xf
    v_add_f32_dpp v40, v40, v40 row_ror:4 row_mask:0xf bank_mask:0xf
    v_add_f32_dpp v41, v41, v41 row_ror:4 row_mask:0xf bank_mask:0xf
    v_add_f32_dpp v42, v42, v42 row_ror:4 row_mask:0xf bank_mask:0xf
    v_add_f32_dpp v43, v43, v43 row_ror:4 row_mask:0xf bank_mask:0xf
    v_cvt_pk_bf16_f32 v36, v40, v41
    v_cvt_pk_bf16_f32 v37, v42, v43
    ds_write_b64 v214, v[36:37]
    s_waitcnt lgkmcnt(0)
    s_barrier
    ds_read_b128 v[36:39], v215
    ds_read_b64_tr_b16 v[64:65], v216
    ds_read_b64_tr_b16 v[66:67], v216 offset:2048
    ds_read_b64_tr_b16 v[72:73], v217
    ds_read_b64_tr_b16 v[74:75], v217 offset:2048
    ds_read_b128 v[40:43], v215 offset:64
    ds_read_b64_tr_b16 v[68:69], v216 offset:4096
    ds_read_b64_tr_b16 v[70:71], v216 offset:6144
    ds_read_b64_tr_b16 v[76:77], v217 offset:4096
    ds_read_b64_tr_b16 v[78:79], v217 offset:6144
    s_waitcnt lgkmcnt(7)
    v_mfma_f32_16x16x32_bf16 v[144:147], v[36:39], v[64:67], 0
    s_waitcnt lgkmcnt(5)
    v_mfma_f32_16x16x32_bf16 v[148:151], v[36:39], v[72:75], 0
    s_waitcnt lgkmcnt(2)
    v_mfma_f32_16x16x32_bf16 v[144:147], v[40:43], v[68:71], v[144:147]
    s_waitcnt lgkmcnt(0)
    v_mfma_f32_16x16x32_bf16 v[148:151], v[40:43], v[76:79], v[148:151]
    s_mov_b64 exec, 0xffff
    s_mov_b64 s[50:51], -1
    s_mov_b32 s32, 1048576
    s_add_u32 s29, s21, s20
    s_cmp_ge_u32 s29, 7
    s_nop 0
    v_bfi_b32 v48, s48, v220, v144
    v_bfi_b32 v49, s48, v221, v145
    v_bfi_b32 v50, s48, v222, v146
    v_bfi_b32 v51, s48, v223, v147
    s_mov_b32 exec_lo, 0xffff0000
    v_bfi_b32 v48, s48, v220, v148
    v_bfi_b32 v49, s48, v221, v149
    v_bfi_b32 v50, s48, v222, v150
    v_bfi_b32 v51, s48, v223, v151
    s_mov_b32 exec_lo, -1
    global_store_dwordx4 v204, v[48:51], s[18:19] sc1
    s_cbranch_scc1 L_done
    s_waitcnt vmcnt(0)
L_opoll:
    s_mov_b64 exec, s[50:51]
    global_load_dwordx4 v[24:27], v205, s[18:19] sc1
    global_load_dwordx4 v[28:31], v207, s[18:19] sc1
    s_sub_u32 s32, s32, 1
    s_cbranch_scc1 L_ogot
    s_waitcnt vmcnt(0)
L_ochk:
    v_xor_b32 v24, v220, v24
    v_xor_b32 v25, v221, v25
    v_xor_b32 v26, v222, v26
    v_xor_b32 v27, v223, v27
    v_xor_b32 v28, v220, v28
    v_xor_b32 v29, v221, v29
    v_xor_b32 v30, v222, v30
    v_xor_b32 v31, v223, v31
    v_or3_b32 v32, v24, v25, v26
    v_or3_b32 v33, v27, v28, v29
    v_or3_b32 v34, v30, v31, v32
    v_or_b32 v35, v33, v34
    v_cmpx_eq_u32_sdwa vcc, v35, 0 src0_sel:BYTE_0 src1_sel:DWORD
    s_andn2_b64 s[50:51], s[50:51], exec
    s_wqm_b64 s[50:51], s[50:51]
    s_cbranch_scc1 L_opoll
L_ogot:
    s_mov_b64 exec, -1
    v_add_f32 v24, v24, v28
    v_add_f32 v26, v26, v30
    v_add_f32 v25, v25, v29
    v_add_f32 v27, v27, v31
    v_permlane32_swap_b32 v24, v26
    v_add_f32 v24, v24, v26
    v_permlane32_swap_b32 v25, v27
    v_add_f32 v25, v25, v27
    s_nop 1
    v_permlane16_swap_b32 v24, v25
    v_add_f32 v24, v24, v25
    s_nop 1
    v_add_f32_dpp v24, v24, v24 row_ror:8 row_mask:0xf bank_mask:0xf
    s_nop 1
    v_add_f32_dpp v24, v24, v24 row_ror:4 row_mask:0xf bank_mask:0xf
    s_nop 1
    v_add_f32_dpp v24, v24, v24 row_ror:2 row_mask:0xf bank_mask:0xf
    s_cmp_lg_u32 s2, 0
    s_nop 0
    v_mov_b32_dpp v28, v24 quad_perm:[1,0,3,2] row_mask:0xf bank_mask:0xf
    s_mov_b32 exec_lo, 0x00010001
    s_mov_b32 exec_hi, 0x00010001
    v_cvt_pk_bf16_f32 v24, v24, v28
    global_store_dword v206, v24, s[14:15]
    s_cbranch_scc1 L_done
    s_mov_b64 exec, 1
    v_mov_b32 v206, 1835008
    global_store_dword v206, v208, s[18:19]
L_done:
    s_endpgm
L_statfar:
    global_store_dwordx2 v200, v[212:213], s[18:19] sc1
    s_branch L_statdone
L_xfar:
    global_store_dwordx4 v202, v[56:59], s[18:19] sc1
    s_branch L_xdone
L_sretry:
    s_sub_u32 s32, s32, 1
    s_cbranch_scc1 L_sgot
    global_load_dwordx4 v[48:51], v201, s[18:19] sc1
    s_waitcnt vmcnt(0)
    s_branch L_schk
L_comm:
    s_setprio 3
    s_add_u32 s40, s18, 0x1c0000
    s_addc_u32 s41, s19, 0
    s_load_dword s30, s[40:41], 0
    v_lshrrev_b32 v8, 2, v0
    v_lshlrev_b32 v8, 7, v8
    v_lshl_add_u32 v8, v4, 3, v8
    v_bfe_u32 v9, v0, 3, 2
    v_lshl_add_u32 v8, v9, 5, v8
    v_add_u32 v8, 81920, v8
    v_xor_b32 v9, 32, v8
    v_xor_b32 v10, 64, v8
    v_xor_b32 v11, 96, v8
    v_lshlrev_b32 v7, 8, v5
    v_lshl_add_u32 v7, v6, 3, v7
    v_add_u32 v7, 96256, v7
    s_and_b32 s23, s22, 3
    s_lshl_b32 s29, s23, 13
    s_add_u32 s29, s29, s27
    s_add_u32 s29, s29, 4096
    v_lshl_add_u32 v14, v0, 4, s29
    v_lshlrev_b32 v15, 7, v6
    v_lshl_add_u32 v15, v4, 5, v15
    v_lshl_add_u32 v15, v5, 3, v15
    v_add_u32 v15, 97280, v15
    v_mov_b32 v46, 98304
    s_movk_i32 s31, 0xff
    s_mov_b32 s53, 0x193311
    s_getreg_b32 s34, hwreg(HW_REG_XCC_ID, 0, 4)
    s_mov_b32 s33, 0
    s_mov_b32 s32, 32768
    s_mov_b64 s[50:51], -1
    s_waitcnt vmcnt(1) lgkmcnt(0)
    s_add_u32 s30, s30, 1
    ds_read2_b64 v[32:35], v7 offset0:0 offset1:4
    ds_read_b64_tr_b16 v[64:65], v8 offset:0
    ds_read_b64_tr_b16 v[66:67], v8 offset:2048
    ds_read_b64_tr_b16 v[68:69], v9 offset:0
    ds_read_b64_tr_b16 v[70:71], v9 offset:2048
    ds_read_b64_tr_b16 v[72:73], v10 offset:0
    ds_read_b64_tr_b16 v[74:75], v10 offset:2048
    ds_read_b64_tr_b16 v[76:77], v11 offset:0
    ds_read_b64_tr_b16 v[78:79], v11 offset:2048
    ds_read2_b64 v[36:39], v7 offset0:8 offset1:12
    ds_read_b64_tr_b16 v[80:81], v8 offset:4096
    ds_read_b64_tr_b16 v[82:83], v8 offset:6144
    ds_read_b64_tr_b16 v[84:85], v9 offset:4096
    v_mov_b32 v62, s30
    v_mov_b32 v63, 0
    v_and_b32 v12, 1, v0
    v_mad_u32_u24 v59, v12, s53, v62
    v_bfe_u32 v56, v59, 0, 8
    v_bfe_u32 v57, v59, 8, 8
    v_bfe_u32 v58, v59, 16, 8
    v_bfe_u32 v59, v59, 24, 8
    v_xor_b32 v59, s34, v59
    s_waitcnt lgkmcnt(10)
    v_mfma_f32_16x16x32_bf16 v[16:19], v[64:67], v[32:35], 0
    ds_read_b64_tr_b16 v[86:87], v9 offset:6144
    ds_read_b64_tr_b16 v[88:89], v10 offset:4096
    s_waitcnt lgkmcnt(10)
    v_mfma_f32_16x16x32_bf16 v[20:23], v[68:71], v[32:35], 0
    ds_read_b64_tr_b16 v[90:91], v10 offset:6144
    ds_read_b64_tr_b16 v[92:93], v11 offset:4096
    s_waitcnt lgkmcnt(10)
    v_mfma_f32_16x16x32_bf16 v[24:27], v[72:75], v[32:35], 0
    ds_read_b64_tr_b16 v[94:95], v11 offset:6144
    ds_read2_b64 v[40:43], v7 offset0:16 offset1:20
    s_waitcnt lgkmcnt(10)
    v_mfma_f32_16x16x32_bf16 v[28:31], v[76:79], v[32:35], 0
    ds_read_b64_tr_b16 v[96:97], v8 offset:8192
    ds_read_b64_tr_b16 v[98:99], v8 offset:10240
    s_waitcnt lgkmcnt(9)
    v_mfma_f32_16x16x32_bf16 v[16:19], v[80:83], v[36:39], v[16:19]
    ds_read_b64_tr_b16 v[100:101], v9 offset:8192
    ds_read_b64_tr_b16 v[102:103], v9 offset:10240
    s_waitcnt lgkmcnt(9)
    v_mfma_f32_16x16x32_bf16 v[20:23], v[84:87], v[36:39], v[20:23]
    ds_read_b64_tr_b16 v[104:105], v10 offset:8192
    ds_read_b64_tr_b16 v[106:107], v10 offset:10240
    s_waitcnt lgkmcnt(9)
    v_mfma_f32_16x16x32_bf16 v[24:27], v[88:91], v[36:39], v[24:27]
    ds_read_b64_tr_b16 v[108:109], v11 offset:8192
    ds_read_b64_tr_b16 v[110:111], v11 offset:10240
    s_waitcnt lgkmcnt(9)
    v_mfma_f32_16x16x32_bf16 v[28:31], v[92:95], v[36:39], v[28:31]
    ds_read_b64 v[44:45], v7 offset:192
    ds_read_b64_tr_b16 v[112:113], v8 offset:12288
    s_waitcnt lgkmcnt(8)
    v_mfma_f32_16x16x32_bf16 v[16:19], v[96:99], v[40:43], v[16:19]
    ds_read_b64_tr_b16 v[116:117], v9 offset:12288
    ds_read_b64_tr_b16 v[120:121], v10 offset:12288
    s_waitcnt lgkmcnt(8)
    v_mfma_f32_16x16x32_bf16 v[20:23], v[100:103], v[40:43], v[20:23]
    ds_read_b64_tr_b16 v[124:125], v11 offset:12288
    s_waitcnt lgkmcnt(7)
    v_mfma_f32_16x16x32_bf16 v[24:27], v[104:107], v[40:43], v[24:27]
    s_waitcnt lgkmcnt(5)
    v_mfma_f32_16x16x32_bf16 v[28:31], v[108:111], v[40:43], v[28:31]
    s_waitcnt lgkmcnt(3)
    v_mfma_f32_16x16x16_bf16 v[16:19], v[112:113], v[44:45], v[16:19]
    s_waitcnt lgkmcnt(2)
    v_mfma_f32_16x16x16_bf16 v[20:23], v[116:117], v[44:45], v[20:23]
    s_waitcnt lgkmcnt(1)
    v_mfma_f32_16x16x16_bf16 v[24:27], v[120:121], v[44:45], v[24:27]
    s_waitcnt lgkmcnt(0)
    v_mfma_f32_16x16x16_bf16 v[28:31], v[124:125], v[44:45], v[28:31]
    s_nop 0
    s_mov_b32 exec_lo, 0x11111111
    s_mov_b32 exec_hi, 0x11111111
    s_nop 1
    v_bfi_b32 v48, s31, v56, v16
    v_bfi_b32 v49, s31, v57, v17
    v_bfi_b32 v50, s31, v58, v18
    v_bfi_b32 v51, s31, v59, v19
    s_lshl_b64 exec, exec, 1
    v_bfi_b32 v48, s31, v56, v20
    v_bfi_b32 v49, s31, v57, v21
    v_bfi_b32 v50, s31, v58, v22
    v_bfi_b32 v51, s31, v59, v23
    s_lshl_b64 exec, exec, 1
    v_bfi_b32 v48, s31, v56, v24
    v_bfi_b32 v49, s31, v57, v25
    v_bfi_b32 v50, s31, v58, v26
    v_bfi_b32 v51, s31, v59, v27
    s_lshl_b64 exec, exec, 1
    v_bfi_b32 v48, s31, v56, v28
    v_bfi_b32 v49, s31, v57, v29
    v_bfi_b32 v50, s31, v58, v30
    v_bfi_b32 v51, s31, v59, v31
    s_mov_b64 exec, -1
    global_store_dwordx4 v13, v[48:51], s[18:19]
    s_waitcnt vmcnt(0)
    v_mov_b32 v61, 0
    global_load_dword v60, v61, s[16:17] sc1
L_qpoll:
    s_mov_b64 exec, s[50:51]
    global_load_dwordx4 v[64:67], v14, s[18:19] offset:-4096 sc1
    global_load_dwordx4 v[68:71], v14, s[18:19] offset:-3072 sc1
    global_load_dwordx4 v[72:75], v14, s[18:19] offset:-2048 sc1
    global_load_dwordx4 v[76:79], v14, s[18:19] offset:-1024 sc1
    global_load_dwordx4 v[80:83], v14, s[18:19] offset:0 sc1
    global_load_dwordx4 v[84:87], v14, s[18:19] offset:1024 sc1
    global_load_dwordx4 v[88:91], v14, s[18:19] offset:2048 sc1
    global_load_dwordx4 v[92:95], v14, s[18:19] offset:3072 sc1
    s_waitcnt vmcnt(0)
    v_xor_b32 v64, v56, v64
    v_xor_b32 v65, v57, v65
    v_xor_b32 v66, v58, v66
    v_xor_b32 v67, v59, v67
    v_xor_b32 v68, v56, v68
    v_xor_b32 v69, v57, v69
    v_xor_b32 v70, v58, v70
    v_xor_b32 v71, v59, v71
    v_xor_b32 v72, v56, v72
    v_xor_b32 v73, v57, v73
    v_xor_b32 v74, v58, v74
    v_xor_b32 v75, v59, v75
    v_xor_b32 v76, v56, v76
    v_xor_b32 v77, v57, v77
    v_xor_b32 v78, v58, v78
    v_xor_b32 v79, v59, v79
    v_xor_b32 v80, v56, v80
    v_xor_b32 v81, v57, v81
    v_xor_b32 v82, v58, v82
    v_xor_b32 v83, v59, v83
    v_xor_b32 v84, v56, v84
    v_xor_b32 v85, v57, v85
    v_xor_b32 v86, v58, v86
    v_xor_b32 v87, v59, v87
    v_xor_b32 v88, v56, v88
    v_xor_b32 v89, v57, v89
    v_xor_b32 v90, v58, v90
    v_xor_b32 v91, v59, v91
    v_xor_b32 v92, v56, v92
    v_xor_b32 v93, v57, v93
    v_xor_b32 v94, v58, v94
    v_xor_b32 v95, v59, v95
    v_or3_b32 v96, v64, v65, v66
    v_or3_b32 v97, v67, v68, v69
    v_or3_b32 v98, v70, v71, v72
    v_or3_b32 v99, v73, v74, v75
    v_or3_b32 v100, v76, v77, v78
    v_or3_b32 v101, v79, v80, v81
    v_or3_b32 v102, v82, v83, v84
    v_or3_b32 v103, v85, v86, v87
    v_or3_b32 v104, v88, v89, v90
    v_or3_b32 v105, v91, v92, v93
    v_or3_b32 v106, v94, v95, v96
    v_or3_b32 v107, v97, v98, v99
    v_or3_b32 v108, v100, v101, v102
    v_or3_b32 v109, v103, v104, v105
    v_or3_b32 v110, v106, v107, v108
    v_or_b32 v111, v109, v110
    v_cmpx_eq_u32_sdwa vcc, v111, 0 src0_sel:BYTE_0 src1_sel:DWORD
    s_andn2_b64 s[50:51], s[50:51], exec
    s_wqm_b64 s[50:51], s[50:51]
    s_cbranch_scc0 L_qgot
    s_add_u32 s33, s33, 0x8000000
    s_cbranch_scc0 L_qpoll
    s_mov_b64 exec, -1
    v_mov_b32 v52, v48
    v_mov_b32 v53, v49
    v_mov_b32 v54, v50
    v_xor_b32 v55, s34, v51
    v_xor_b32 v47, 0x1c0000, v13
    global_store_dwordx4 v47, v[52:55], s[18:19] sc1
    v_xor_b32 v14, 0x1c0000, v14
    v_xor_b32 v59, s34, v59
    v_mov_b32 v63, 1
    s_sub_u32 s32, s32, 1
    s_cbranch_scc0 L_qpoll
L_qgot:
    s_mov_b64 exec, -1
    v_pk_add_f32 v[64:65], v[64:65], v[80:81]
    v_pk_add_f32 v[66:67], v[66:67], v[82:83]
    v_pk_add_f32 v[68:69], v[68:69], v[84:85]
    v_pk_add_f32 v[70:71], v[70:71], v[86:87]
    v_pk_add_f32 v[72:73], v[72:73], v[88:89]
    v_pk_add_f32 v[74:75], v[74:75], v[90:91]
    v_pk_add_f32 v[76:77], v[76:77], v[92:93]
    v_pk_add_f32 v[78:79], v[78:79], v[94:95]
    v_pk_add_f32 v[64:65], v[64:65], v[72:73]
    v_pk_add_f32 v[66:67], v[66:67], v[74:75]
    v_pk_add_f32 v[68:69], v[68:69], v[76:77]
    v_pk_add_f32 v[70:71], v[70:71], v[78:79]
    v_cvt_pk_bf16_f32 v52, v64, v65
    v_cvt_pk_bf16_f32 v53, v66, v67
    v_cvt_pk_bf16_f32 v54, v68, v69
    v_cvt_pk_bf16_f32 v55, v70, v71
    ds_write_b64 v15, v[52:53]
    ds_write_b64 v15, v[54:55] offset:512
    s_mov_b32 s32, 1048576
L_side:
    v_readfirstlane_b32 s29, v60
    s_cmp_lg_u32 s29, 0
    s_cbranch_scc1 L_sideok
    global_load_dword v60, v61, s[16:17] sc1
    s_waitcnt vmcnt(0)
    s_sub_u32 s32, s32, 1
    s_cbranch_scc0 L_side
L_sideok:
    v_and_b32 v60, 1, v60
    v_lshl_or_b32 v63, v60, 13, v63
    ds_write_b64 v46, v[62:63]
    s_waitcnt lgkmcnt(0)
    s_barrier
L_fin:
L_end:
    s_endpgm
    .fill (standalone__sliding_block_cached__decode_kernel + 8704 - .) / 4, 4, 0xbf810000
.section .rodata,"a"
.p2align 6
.amdhsa_kernel standalone__sliding_block_cached__decode_kernel
  .amdhsa_next_free_vgpr 224
  .amdhsa_next_free_sgpr 64
  .amdhsa_accum_offset 224
  .amdhsa_group_segment_fixed_size 0
  .amdhsa_kernarg_size 64
  .amdhsa_user_sgpr_count 2
  .amdhsa_user_sgpr_kernarg_segment_ptr 1
  .amdhsa_system_sgpr_workgroup_id_x 1
  .amdhsa_float_denorm_mode_32 3
.end_amdhsa_kernel
```
